```python
import torch

def _softmax(x, axis=-1):
    return torch.softmax(x, dim=axis)
def _gelu(x):
    return torch.nn.functional.gelu(x, approximate="tanh")
def _silu(x):
    return torch.nn.functional.silu(x)
def _sigmoid(x):
    return torch.sigmoid(x)
def _layernorm(x, axis=-1, eps=1e-5):
    m = x.mean(dim=axis, keepdim=True)
    v = x.var(dim=axis, keepdim=True, unbiased=False)
    return (x - m) / torch.sqrt(v + eps)
def _scatter_add(tgt, idx, src, axis=0):
    return tgt.clone().index_add_(axis, idx, src)
def _segment_sum(src, seg, n):
    out = torch.zeros((n,) + src.shape[1:], dtype=src.dtype)
    return out.index_add_(0, seg, src)
def _pad(x, pw):
    flat = tuple(v for pair in reversed(pw) for v in pair)
    return torch.nn.functional.pad(x, flat)

kernel_name = 'standalone__fused_io_aware_attn__prompt'

def setup_inputs():

    _w = (lambda a: (lambda t: t.to(torch.bfloat16) if t.is_floating_point() else t)(torch.as_tensor(a)))
    B, H, S = 2, 16, 2048
    Dh = max(1, 448 // 16)
    return {
        "q": _w((lambda *s: torch.randn(*s, dtype=torch.bfloat16) * 0.8)(B, H, S, Dh)),
        "k": _w((lambda *s: torch.randn(*s, dtype=torch.bfloat16) * 0.8)(B, H, S, Dh)),
        "v": _w((lambda *s: torch.randn(*s, dtype=torch.bfloat16) * 0.05)(B, H, S, Dh)),
    }

def reference(q, k, v):
    scale = q.shape[-1] ** -0.5
    s = torch.einsum('bhqd,bhkd->bhqk', q, k) * scale
    p = _softmax(s, axis=-1)
    return torch.einsum('bhqk,bhkd->bhqd', p, v)
```

```asm
; @launch grid=(256,1,1) block=(512,1,1) lds=157696
.amdgcn_target "amdgcn-amd-amdhsa--gfx950"
.text
.globl standalone__fused_io_aware_attn__prompt_kernel
.p2align 8
.type standalone__fused_io_aware_attn__prompt_kernel,@function
standalone__fused_io_aware_attn__prompt_kernel:
    s_load_dwordx2 s[12:13], s[0:1], 0
    s_load_dwordx2 s[24:25], s[0:1], 8
    s_load_dwordx2 s[28:29], s[0:1], 16
    s_load_dwordx2 s[20:21], s[0:1], 24
    s_cmp_ge_u32 s2, 256
    s_cbranch_scc1 L_end
    v_subrev_u32 v170, 192, v0
    s_getpc_b64 s[44:45]
L_pc:
    v_cmp_gt_u32 vcc, 38, v170
    s_and_saveexec_b64 s[46:47], vcc
    s_cbranch_execz L_nocpf
    v_lshlrev_b32 v170, 7, v170
    v_mov_b32 v171, s45
    v_add_co_u32 v170, vcc, s44, v170
    s_nop 1
    v_addc_co_u32 v171, vcc, 0, v171, vcc
    global_load_dword v167, v[170:171], off
L_nocpf:
    s_mov_b64 exec, s[46:47]
    v_lshrrev_b32 v168, 1, v0
    s_and_b32 s44, s2, 7
    v_bfi_b32 v168, 31, v0, v168
    s_mul_i32 s44, s44, 458752
    v_bfe_u32 v156, v0, 5, 1
    s_and_b32 s45, s2, 0xf8
    v_mul_u32_u24 v168, 56, v168
    s_mul_i32 s45, s45, 1792
    v_mad_u32_u24 v159, v156, 24, v168
    s_add_u32 s53, s44, s45
    v_lshrrev_b32 v1, 6, v0
    s_mov_b32 s14, 3670016
    s_mov_b32 s15, 0x00020000
    v_readfirstlane_b32 s32, v1
    v_and_b32 v155, 63, v0
    s_lshr_b32 s45, s2, 6
    s_mul_i32 s45, s45, 114688
    s_add_u32 s34, s44, s45
    v_lshlrev_b32 v3, 4, v155
    s_lshr_b32 s33, s32, 2
    s_and_b32 s48, s32, 1
    s_mul_i32 s47, s33, 57344
    s_lshl_b32 s48, s48, 10
    s_add_u32 s47, s47, s34
    s_lshr_b32 s49, s32, 1
    s_add_u32 s47, s47, s48
    s_mul_i32 s39, s49, 7168
    v_add_u32 v154, s47, v3
    s_add_u32 s39, s39, s48
    s_mov_b32 s18, 3670016
    s_mov_b32 s19, 0x00020000
    s_mov_b32 m0, s39
    s_bitcmp1_b32 s32, 1
    s_waitcnt lgkmcnt(0)
    buffer_load_dwordx4 v[100:103], v159, s[12:15], s53 offen nt
    buffer_load_dwordx4 v[104:107], v159, s[12:15], s53 offen offset:16 nt
    s_cselect_b32 s16, s28, s24
    s_cselect_b32 s17, s29, s25
    s_cbranch_scc1 L_k0
    buffer_load_dwordx4 v154, s[16:19], 0 offen nt lds
L_k0:
    s_sub_u32 s41, 6144, s48
    s_mov_b32 s38, s39
    s_mov_b32 s40, 0
    s_lshl_b32 s44, s32, 12
    s_add_u32 s44, s44, 122880
    s_xor_b32 s45, s32, 4
    s_mul_i32 s46, s45, 1792
    s_add_u32 s52, s53, s46
    s_lshl_b32 s45, s45, 12
    s_add_u32 s50, s45, 122880
    v_add_u32 v158, s44, v3
    v_add_u32 v160, s50, v3
    s_mul_i32 s44, s32, 1792
    v_subrev_u32 v157, s44, v159
    s_mov_b32 s22, 3670016
    s_mov_b32 s23, 0x00020000
    s_mov_b32 s42, 0x3e8b97f6
    s_mov_b32 s43, 0x3e8b97f6
    v_mov_b32 v172, 0x3f80
    v_mov_b32 v173, 0
    v_mov_b32 v174, 0x3f80
    v_mov_b32 v175, 0
    v_lshlrev_b32 v169, 4, v0
    v_add_u32 v169, 114688, v169
    ds_write_b128 v169, v[172:175]
    v_lshlrev_b32 v161, 2, v0
    v_add_u32 v161, 155648, v161
    ds_write_b32 v161, v173
    v_and_b32 v170, 3, v155
    v_lshlrev_b32 v170, 8, v170
    v_lshl_add_u32 v170, v155, 2, v170
    s_lshl_b32 s44, s33, 10
    s_add_u32 s44, s44, 155648
    v_add_u32 v162, s44, v170
    v_xor_b32 v1, 1024, v161
    v_mov_b32 v163, 1
    s_bitcmp1_b32 s32, 1
    s_cbranch_scc0 L_v0
    s_mov_b32 m0, s38
    s_nop 0
    buffer_load_dwordx4 v154, s[16:19], 0 offen nt lds
L_v0:
    s_add_u32 m0, s38, 2048
    s_add_u32 s51, s40, 2048
    buffer_load_dwordx4 v154, s[16:19], s51 offen nt lds
    s_mul_i32 s44, s33, 14336
    v_add_u32 v150, s44, v157
    v_bfe_u32 v169, v155, 2, 2
    v_lshl_add_u32 v169, v156, 3, v169
    v_mul_u32_u24 v169, 56, v169
    v_and_b32 v170, 1, v155
    v_lshlrev_b32 v170, 2, v170
    v_bfe_u32 v171, v155, 4, 1
    v_lshl_add_u32 v170, v171, 1, v170
    v_bfe_u32 v171, v155, 1, 1
    v_add_u32 v170, v170, v171
    v_lshl_add_u32 v165, v170, 3, v169
    s_add_u32 s44, s44, 7168
    v_add_u32 v151, s44, v165
    v_cmp_ne_u32 vcc, 7, v170
    v_mul_u32_u24 v166, 64, v156
    v_sub_u32 v166, 114912, v166
    v_mov_b32 v148, v150
    v_cndmask_b32 v151, v166, v151, vcc
    v_cndmask_b32 v152, 0, 1, vcc
    v_mov_b32 v149, v151
    v_mov_b32 v153, 0xdddddddd
    v_mov_b32 v68, 0
    v_mov_b32 v69, 0
    v_mov_b32 v70, 0
    v_mov_b32 v71, 0
    v_mov_b32 v72, 0
    v_mov_b32 v73, 0
    v_mov_b32 v74, 0
    v_mov_b32 v75, 0
    v_mov_b32 v76, 0
    v_mov_b32 v77, 0
    v_mov_b32 v78, 0
    v_mov_b32 v79, 0
    v_mov_b32 v80, 0
    v_mov_b32 v81, 0
    v_mov_b32 v82, 0
    v_mov_b32 v83, 0
    v_mov_b32 v84, 0
    v_mov_b32 v85, 0
    v_mov_b32 v86, 0
    v_mov_b32 v87, 0
    v_mov_b32 v88, 0
    v_mov_b32 v89, 0
    v_mov_b32 v90, 0
    v_mov_b32 v91, 0
    v_mov_b32 v92, 0
    v_mov_b32 v93, 0
    v_mov_b32 v94, 0
    v_mov_b32 v95, 0
    v_mov_b32 v96, 0
    v_mov_b32 v97, 0
    v_mov_b32 v98, 0
    v_mov_b32 v99, 0
    v_lshl_add_u32 v2, v156, 3, v157
    v_add_u32 v2, s50, v2
    v_cmp_eq_u32 vcc, 0, v156
    v_mov_b32 v168, s42
    s_mov_b32 s35, 0
    v_cndmask_b32 v168, 0, v168, vcc
    s_mov_b32 s88, 0
    s_mov_b64 s[90:91], -1
    s_bitcmp1_b32 s32, 0
    s_cselect_b32 s36, 0, 6
    s_waitcnt vmcnt(2)
    v_lshlrev_b32 v4, 16, v100
    v_and_b32 v5, 0xffff0000, v100
    v_lshlrev_b32 v6, 16, v101
    v_and_b32 v7, 0xffff0000, v101
    v_lshlrev_b32 v8, 16, v102
    v_and_b32 v9, 0xffff0000, v102
    v_lshlrev_b32 v10, 16, v103
    v_and_b32 v11, 0xffff0000, v103
    v_pk_mul_f32 v[4:5], v[4:5], v[168:169] op_sel_hi:[1,0]
    v_pk_mul_f32 v[6:7], v[6:7], v[168:169] op_sel_hi:[1,0]
    v_pk_mul_f32 v[8:9], v[8:9], s[42:43]
    v_pk_mul_f32 v[10:11], v[10:11], s[42:43]
    v_cvt_pk_bf16_f32 v100, v4, v5
    v_cvt_pk_bf16_f32 v101, v6, v7
    v_cvt_pk_bf16_f32 v102, v8, v9
    v_cvt_pk_bf16_f32 v103, v10, v11
    ds_write_b128 v158, v[100:103] offset:0
    v_lshlrev_b32 v12, 16, v104
    v_and_b32 v13, 0xffff0000, v104
    v_lshlrev_b32 v14, 16, v105
    v_and_b32 v15, 0xffff0000, v105
    v_lshlrev_b32 v16, 16, v106
    v_and_b32 v17, 0xffff0000, v106
    v_lshlrev_b32 v18, 16, v107
    v_and_b32 v19, 0xffff0000, v107
    v_pk_mul_f32 v[12:13], v[12:13], s[42:43]
    v_pk_mul_f32 v[14:15], v[14:15], s[42:43]
    v_pk_mul_f32 v[16:17], v[16:17], s[42:43]
    v_pk_mul_f32 v[18:19], v[18:19], s[42:43]
    v_cvt_pk_bf16_f32 v104, v12, v13
    v_cvt_pk_bf16_f32 v105, v14, v15
    v_cvt_pk_bf16_f32 v106, v16, v17
    v_cvt_pk_bf16_f32 v107, v18, v19
    ds_write_b128 v158, v[104:107] offset:1024
    s_add_u32 m0, s38, 4096
    s_add_u32 s51, s40, 4096
    buffer_load_dwordx4 v154, s[16:19], s51 offen nt lds
    s_add_u32 m0, s38, s41
    s_add_u32 s51, s40, s41
    buffer_load_dwordx4 v154, s[16:19], s51 offen nt lds
    s_bitcmp1_b32 s32, 1
    s_cbranch_scc1 L_bar
    s_waitcnt vmcnt(3)
L_bar:
    s_waitcnt lgkmcnt(0)
    s_barrier
    s_setprio 3
    ds_read_b64 v[116:117], v148 offset:0
    ds_read_b64 v[118:119], v148 offset:8
    ds_read_b64 v[120:121], v148 offset:16
    ds_read_b64 v[122:123], v148 offset:24
    ds_read_b128 v[108:111], v160
    ds_read_b128 v[112:115], v160 offset:1024
    s_waitcnt lgkmcnt(2)
    v_mfma_f32_32x32x16_bf16 v[4:19], v[116:119], v[100:103], 0
    v_mfma_f32_32x32x16_bf16 v[4:19], v[120:123], v[104:107], v[4:19]
    s_waitcnt lgkmcnt(0)
    v_mfma_f32_32x32x16_bf16 v[36:51], v[116:119], v[108:111], 0
    s_cmp_eq_u32 s33, 0
    v_mfma_f32_32x32x16_bf16 v[36:51], v[120:123], v[112:115], v[36:51]
    s_cbranch_scc0 L_firstY
    s_setprio 1
    s_nop 5
    v_exp_f32 v4, v4
    v_exp_f32 v5, v5
    v_exp_f32 v6, v6
    v_exp_f32 v7, v7
    v_exp_f32 v8, v8
    v_exp_f32 v9, v9
    v_exp_f32 v10, v10
    v_exp_f32 v11, v11
    v_exp_f32 v12, v12
    v_exp_f32 v13, v13
    v_exp_f32 v14, v14
    v_exp_f32 v15, v15
    v_exp_f32 v16, v16
    v_exp_f32 v17, v17
    v_exp_f32 v18, v18
    v_exp_f32 v19, v19
    v_exp_f32 v36, v36
    v_exp_f32 v37, v37
    v_exp_f32 v38, v38
    v_exp_f32 v39, v39
    v_exp_f32 v40, v40
    v_exp_f32 v41, v41
    v_exp_f32 v42, v42
    v_exp_f32 v43, v43
    v_exp_f32 v44, v44
    v_exp_f32 v45, v45
    v_exp_f32 v46, v46
    v_exp_f32 v47, v47
    v_exp_f32 v48, v48
    v_exp_f32 v49, v49
    v_exp_f32 v50, v50
    v_exp_f32 v51, v51
    s_setprio 3
    s_waitcnt vmcnt(0)
    s_barrier
    ds_read_b64 v[124:125], v148 offset:1792
    ds_read_b64 v[126:127], v148 offset:1800
    ds_read_b64 v[128:129], v148 offset:1808
    ds_read_b64 v[130:131], v148 offset:1816
    ds_read_b64_tr_b16 v[132:133], v149 offset:0
    ds_read_b64_tr_b16 v[134:135], v149 offset:224
    ds_read_b64_tr_b16 v[136:137], v149 offset:896
    ds_read_b64_tr_b16 v[138:139], v149 offset:1120
    s_add_u32 s38, s39, 28672
    s_mov_b32 s40, 7168
    s_add_u32 m0, s38, 0
    s_add_u32 s51, s40, 0
    buffer_load_dwordx4 v154, s[16:19], s51 offen nt lds
    s_waitcnt lgkmcnt(0)
    v_mfma_f32_32x32x16_bf16 v[20:35], v[124:127], v[100:103], 0
    ds_read_b64_tr_b16 v[140:141], v149 offset:1792
    s_add_u32 m0, s38, 2048
    s_add_u32 s51, s40, 2048
    buffer_load_dwordx4 v154, s[16:19], s51 offen nt lds
    v_mfma_f32_32x32x16_bf16 v[20:35], v[128:131], v[104:107], v[20:35]
    ds_read_b64_tr_b16 v[142:143], v149 offset:2016
    v_smfmac_f32_32x32x32_bf16 v[68:83], v[132:135], v[4:11], v153
    ds_read_b64_tr_b16 v[144:145], v149 offset:2688
    s_add_u32 m0, s38, 4096
    s_add_u32 s51, s40, 4096
    buffer_load_dwordx4 v154, s[16:19], s51 offen nt lds
    v_smfmac_f32_32x32x32_bf16 v[68:83], v[136:139], v[12:19], v153
    ds_read_b64_tr_b16 v[146:147], v149 offset:2912
    s_add_u32 m0, s38, s41
    s_add_u32 s51, s40, s41
    buffer_load_dwordx4 v154, s[16:19], s51 offen nt lds
    v_mfma_f32_32x32x16_bf16 v[52:67], v[124:127], v[108:111], 0
    ds_read_b64 v[116:117], v148 offset:3584
    s_add_u32 s38, s39, 57344
    s_mov_b32 s40, 14336
    v_mfma_f32_32x32x16_bf16 v[52:67], v[128:131], v[112:115], v[52:67]
    ds_read_b64 v[118:119], v148 offset:3592
    s_add_u32 m0, s38, 0
    s_add_u32 s51, s40, 0
    buffer_load_dwordx4 v154, s[16:19], s51 offen nt lds
    v_smfmac_f32_32x32x32_bf16 v[84:99], v[132:135], v[36:43], v153
    ds_read_b64 v[120:121], v148 offset:3600
    s_add_u32 m0, s38, 2048
    s_add_u32 s51, s40, 2048
    buffer_load_dwordx4 v154, s[16:19], s51 offen nt lds
    v_smfmac_f32_32x32x32_bf16 v[84:99], v[136:139], v[44:51], v153
    ds_read_b64 v[122:123], v148 offset:3608
    s_mov_b32 s37, 28672
    s_cmp_eq_u32 s35, 1
    s_branch L_E1
L_firstY:
    s_add_u32 s38, s39, 28672
    s_mov_b32 s40, 7168
    s_add_u32 m0, s38, 0
    s_add_u32 s51, s40, 0
    buffer_load_dwordx4 v154, s[16:19], s51 offen nt lds
    s_add_u32 m0, s38, 2048
    s_add_u32 s51, s40, 2048
    buffer_load_dwordx4 v154, s[16:19], s51 offen nt lds
    s_add_u32 m0, s38, 4096
    s_add_u32 s51, s40, 4096
    buffer_load_dwordx4 v154, s[16:19], s51 offen nt lds
    s_add_u32 m0, s38, s41
    s_add_u32 s51, s40, s41
    buffer_load_dwordx4 v154, s[16:19], s51 offen nt lds
    s_add_u32 s38, s39, 57344
    s_mov_b32 s40, 14336
    s_add_u32 m0, s38, 0
    s_add_u32 s51, s40, 0
    buffer_load_dwordx4 v154, s[16:19], s51 offen nt lds
    s_waitcnt vmcnt(5)
    s_barrier
    ds_read_b64 v[124:125], v148 offset:1792
    ds_read_b64 v[126:127], v148 offset:1800
    ds_read_b64 v[128:129], v148 offset:1808
    ds_read_b64 v[130:131], v148 offset:1816
    ds_read_b64_tr_b16 v[132:133], v149 offset:0
    ds_read_b64_tr_b16 v[134:135], v149 offset:224
    ds_read_b64_tr_b16 v[136:137], v149 offset:896
    ds_read_b64_tr_b16 v[138:139], v149 offset:1120
    s_branch L_E0
.p2align 6
L_loop:
    s_setprio 3
    v_mad_u32_u24 v149, s37, v152, v151
    s_waitcnt lgkmcnt(0)
    v_mfma_f32_32x32x16_bf16 v[4:19], v[116:119], v[100:103], 0
    ds_read_b64_tr_b16 v[132:133], v149 offset:0
    v_mfma_f32_32x32x16_bf16 v[4:19], v[120:123], v[104:107], v[4:19]
    ds_read_b64_tr_b16 v[134:135], v149 offset:224
    s_add_u32 s44, s35, 2
    s_and_b32 s44, s44, 3
    s_mul_i32 s44, s44, 28672
    v_smfmac_f32_32x32x32_bf16 v[68:83], v[140:143], v[20:27], v153
    ds_read_b64_tr_b16 v[136:137], v149 offset:896
    s_add_u32 s38, s44, s39
    s_add_u32 s40, s40, 7168
    v_smfmac_f32_32x32x32_bf16 v[68:83], v[144:147], v[28:35], v153
    ds_read_b64_tr_b16 v[138:139], v149 offset:1120
    v_mfma_f32_32x32x16_bf16 v[36:51], v[116:119], v[108:111], 0
    ds_read_b64 v[124:125], v148 offset:1792
    v_mfma_f32_32x32x16_bf16 v[36:51], v[120:123], v[112:115], v[36:51]
    ds_read_b64 v[126:127], v148 offset:1800
    s_cmp_lt_u32 s35, 6
    s_cbranch_scc0 L_nodma0
    s_add_u32 m0, s38, 0
    s_add_u32 s51, s40, 0
    buffer_load_dwordx4 v154, s[16:19], s51 offen nt lds
L_nodma0:
    v_smfmac_f32_32x32x32_bf16 v[84:99], v[140:143], v[52:59], v153
    ds_read_b64 v[128:129], v148 offset:1808
    v_smfmac_f32_32x32x32_bf16 v[84:99], v[144:147], v[60:67], v153
    ds_read_b64 v[130:131], v148 offset:1816
L_E0:
    s_setprio 0
    v_exp_f32 v4, v4
    v_exp_f32 v5, v5
    v_exp_f32 v6, v6
    v_exp_f32 v7, v7
    v_exp_f32 v8, v8
    v_exp_f32 v9, v9
    v_exp_f32 v10, v10
    s_setprio 1
    v_exp_f32 v11, v11
    v_exp_f32 v12, v12
    v_exp_f32 v13, v13
    v_exp_f32 v14, v14
    v_exp_f32 v15, v15
    v_exp_f32 v16, v16
    v_exp_f32 v17, v17
    v_exp_f32 v18, v18
    v_exp_f32 v19, v19
    v_exp_f32 v36, v36
    v_exp_f32 v37, v37
    v_exp_f32 v38, v38
    v_exp_f32 v39, v39
    v_exp_f32 v40, v40
    v_exp_f32 v41, v41
    v_exp_f32 v42, v42
    v_exp_f32 v43, v43
    v_exp_f32 v44, v44
    v_exp_f32 v45, v45
    v_exp_f32 v46, v46
    v_exp_f32 v47, v47
    v_exp_f32 v48, v48
    v_exp_f32 v49, v49
    v_exp_f32 v50, v50
    v_exp_f32 v51, v51
    s_setprio 3
    s_waitcnt lgkmcnt(0)
    v_mfma_f32_32x32x16_bf16 v[20:35], v[124:127], v[100:103], 0
    ds_read_b64_tr_b16 v[140:141], v149 offset:1792
    v_mfma_f32_32x32x16_bf16 v[20:35], v[128:131], v[104:107], v[20:35]
    ds_read_b64_tr_b16 v[142:143], v149 offset:2016
    v_smfmac_f32_32x32x32_bf16 v[68:83], v[132:135], v[4:11], v153
    ds_read_b64_tr_b16 v[144:145], v149 offset:2688
    v_smfmac_f32_32x32x32_bf16 v[68:83], v[136:139], v[12:19], v153
    ds_read_b64_tr_b16 v[146:147], v149 offset:2912
    v_mfma_f32_32x32x16_bf16 v[52:67], v[124:127], v[108:111], 0
    ds_read_b64 v[116:117], v148 offset:3584
    v_mfma_f32_32x32x16_bf16 v[52:67], v[128:131], v[112:115], v[52:67]
    ds_read_b64 v[118:119], v148 offset:3592
    s_cmp_lt_u32 s35, 6
    s_cbranch_scc0 L_nodma1
    s_add_u32 m0, s38, 2048
    s_add_u32 s51, s40, 2048
    buffer_load_dwordx4 v154, s[16:19], s51 offen nt lds
L_nodma1:
    v_smfmac_f32_32x32x32_bf16 v[84:99], v[132:135], v[36:43], v153
    ds_read_b64 v[120:121], v148 offset:3600
    s_add_u32 s44, s35, 1
    s_and_b32 s44, s44, 3
    s_mul_i32 s37, s44, 28672
    v_smfmac_f32_32x32x32_bf16 v[84:99], v[136:139], v[44:51], v153
    ds_read_b64 v[122:123], v148 offset:3608
    s_cmp_eq_u32 s35, 7
L_E1:
    s_setprio 0
    v_exp_f32 v20, v20
    v_exp_f32 v21, v21
    v_exp_f32 v22, v22
    v_exp_f32 v23, v23
    v_exp_f32 v24, v24
    v_exp_f32 v25, v25
    v_exp_f32 v26, v26
    s_setprio 1
    v_exp_f32 v27, v27
    v_exp_f32 v28, v28
    v_exp_f32 v29, v29
    v_exp_f32 v30, v30
    v_exp_f32 v31, v31
    v_exp_f32 v32, v32
    v_exp_f32 v33, v33
    v_exp_f32 v34, v34
    v_exp_f32 v35, v35
    v_exp_f32 v52, v52
    v_exp_f32 v53, v53
    v_exp_f32 v54, v54
    v_exp_f32 v55, v55
    v_exp_f32 v56, v56
    v_exp_f32 v57, v57
    v_exp_f32 v58, v58
    v_exp_f32 v59, v59
    v_exp_f32 v60, v60
    v_exp_f32 v61, v61
    v_exp_f32 v62, v62
    v_exp_f32 v63, v63
    v_exp_f32 v64, v64
    v_exp_f32 v65, v65
    v_exp_f32 v66, v66
    v_exp_f32 v67, v67
    s_cbranch_scc1 L_tail
    s_setprio 3
    s_waitcnt lgkmcnt(0)
    v_mfma_f32_32x32x16_bf16 v[4:19], v[116:119], v[100:103], 0
    ds_read_b64_tr_b16 v[132:133], v149 offset:3584
    v_mfma_f32_32x32x16_bf16 v[4:19], v[120:123], v[104:107], v[4:19]
    ds_read_b64_tr_b16 v[134:135], v149 offset:3808
    v_smfmac_f32_32x32x32_bf16 v[68:83], v[140:143], v[20:27], v153
    ds_read_b64_tr_b16 v[136:137], v149 offset:4480
    v_smfmac_f32_32x32x32_bf16 v[68:83], v[144:147], v[28:35], v153
    ds_read_b64_tr_b16 v[138:139], v149 offset:4704
    v_mfma_f32_32x32x16_bf16 v[36:51], v[116:119], v[108:111], 0
    ds_read_b64 v[124:125], v148 offset:5376
    v_mfma_f32_32x32x16_bf16 v[36:51], v[120:123], v[112:115], v[36:51]
    ds_read_b64 v[126:127], v148 offset:5384
    s_cmp_lt_u32 s35, 6
    s_cbranch_scc0 L_nodma2
    s_add_u32 m0, s38, 4096
    s_add_u32 s51, s40, 4096
    buffer_load_dwordx4 v154, s[16:19], s51 offen nt lds
L_nodma2:
    v_smfmac_f32_32x32x32_bf16 v[84:99], v[140:143], v[52:59], v153
    ds_read_b64 v[128:129], v148 offset:5392
    v_smfmac_f32_32x32x32_bf16 v[84:99], v[144:147], v[60:67], v153
    ds_read_b64 v[130:131], v148 offset:5400
    s_setprio 0
    v_exp_f32 v4, v4
    v_exp_f32 v5, v5
    v_exp_f32 v6, v6
    v_exp_f32 v7, v7
    v_exp_f32 v8, v8
    v_exp_f32 v9, v9
    v_exp_f32 v10, v10
    s_setprio 1
    v_exp_f32 v11, v11
    v_exp_f32 v12, v12
    v_exp_f32 v13, v13
    v_exp_f32 v14, v14
    v_exp_f32 v15, v15
    v_exp_f32 v16, v16
    v_exp_f32 v17, v17
    v_exp_f32 v18, v18
    v_exp_f32 v19, v19
    v_exp_f32 v36, v36
    v_exp_f32 v37, v37
    v_exp_f32 v38, v38
    v_exp_f32 v39, v39
    v_exp_f32 v40, v40
    v_exp_f32 v41, v41
    v_exp_f32 v42, v42
    v_exp_f32 v43, v43
    v_exp_f32 v44, v44
    v_exp_f32 v45, v45
    v_exp_f32 v46, v46
    v_exp_f32 v47, v47
    v_exp_f32 v48, v48
    v_exp_f32 v49, v49
    v_exp_f32 v50, v50
    v_exp_f32 v51, v51
    s_setprio 3
    s_waitcnt lgkmcnt(0)
    v_mfma_f32_32x32x16_bf16 v[20:35], v[124:127], v[100:103], 0
    s_waitcnt vmcnt(3)
    s_cmp_lt_u32 s35, 6
    s_cbranch_scc1 L_w2
    s_waitcnt vmcnt(0)
L_w2:
    ds_add_u32 v161, v163
    ds_read_b64_tr_b16 v[140:141], v149 offset:5376
    v_mfma_f32_32x32x16_bf16 v[20:35], v[128:131], v[104:107], v[20:35]
    ds_read_b64_tr_b16 v[142:143], v149 offset:5600
    s_add_u32 s88, s88, 1
    v_add_u32 v148, s37, v150
    v_smfmac_f32_32x32x32_bf16 v[68:83], v[132:135], v[4:11], v153
    ds_read_b64_tr_b16 v[144:145], v149 offset:6272
    s_cmp_lt_u32 s35, s36
    s_cbranch_scc0 L_nodma3
    s_add_u32 m0, s38, s41
    s_add_u32 s51, s40, s41
    buffer_load_dwordx4 v154, s[16:19], s51 offen nt lds
L_nodma3:
    v_smfmac_f32_32x32x32_bf16 v[68:83], v[136:139], v[12:19], v153
    ds_read_b64_tr_b16 v[146:147], v149 offset:6496
    ds_read_b32 v164, v162
    v_mfma_f32_32x32x16_bf16 v[52:67], v[124:127], v[108:111], 0
    v_mfma_f32_32x32x16_bf16 v[52:67], v[128:131], v[112:115], v[52:67]
    s_waitcnt lgkmcnt(0)
    v_cmp_gt_u32 vcc, s88, v164
    s_cbranch_vccnz L_poll
L_pollok:
    ds_read_b64 v[116:117], v148 offset:0
    v_smfmac_f32_32x32x32_bf16 v[84:99], v[132:135], v[36:43], v153
    ds_read_b64 v[118:119], v148 offset:8
    ds_read_b64 v[120:121], v148 offset:16
    s_add_u32 s35, s35, 1
    v_smfmac_f32_32x32x32_bf16 v[84:99], v[136:139], v[44:51], v153
    ds_read_b64 v[122:123], v148 offset:24
    s_setprio 0
    v_exp_f32 v20, v20
    v_exp_f32 v21, v21
    v_exp_f32 v22, v22
    v_exp_f32 v23, v23
    v_exp_f32 v24, v24
    v_exp_f32 v25, v25
    v_exp_f32 v26, v26
    s_setprio 1
    v_exp_f32 v27, v27
    v_exp_f32 v28, v28
    v_exp_f32 v29, v29
    v_exp_f32 v30, v30
    v_exp_f32 v31, v31
    v_exp_f32 v32, v32
    v_exp_f32 v33, v33
    v_exp_f32 v34, v34
    v_exp_f32 v35, v35
    v_exp_f32 v52, v52
    v_exp_f32 v53, v53
    v_exp_f32 v54, v54
    v_exp_f32 v55, v55
    v_exp_f32 v56, v56
    v_exp_f32 v57, v57
    v_exp_f32 v58, v58
    v_exp_f32 v59, v59
    v_exp_f32 v60, v60
    v_exp_f32 v61, v61
    v_exp_f32 v62, v62
    v_exp_f32 v63, v63
    v_exp_f32 v64, v64
    v_exp_f32 v65, v65
    v_exp_f32 v66, v66
    v_exp_f32 v67, v67
    s_branch L_loop
L_poll:
    ds_read_b32 v164, v162
    s_waitcnt lgkmcnt(0)
    v_cmp_gt_u32 vcc, s88, v164
    s_cbranch_vccnz L_poll
    s_branch L_pollok
L_tail:
    s_setprio 3
    s_waitcnt lgkmcnt(0)
    v_mfma_f32_32x32x16_bf16 v[4:19], v[116:119], v[100:103], 0
    ds_read_b64 v[124:125], v148 offset:5376
    ds_read_b64 v[126:127], v148 offset:5384
    v_mfma_f32_32x32x16_bf16 v[4:19], v[120:123], v[104:107], v[4:19]
    ds_read_b64 v[128:129], v148 offset:5392
    ds_read_b64 v[130:131], v148 offset:5400
    v_smfmac_f32_32x32x32_bf16 v[68:83], v[140:143], v[20:27], v153
    ds_read_b64_tr_b16 v[132:133], v149 offset:3584
    ds_read_b64_tr_b16 v[134:135], v149 offset:3808
    v_smfmac_f32_32x32x32_bf16 v[68:83], v[144:147], v[28:35], v153
    ds_read_b64_tr_b16 v[136:137], v149 offset:4480
    ds_read_b64_tr_b16 v[138:139], v149 offset:4704
    v_smfmac_f32_32x32x32_bf16 v[84:99], v[140:143], v[52:59], v153
    v_smfmac_f32_32x32x32_bf16 v[84:99], v[144:147], v[60:67], v153
    s_waitcnt lgkmcnt(4)
    ds_read_b64_tr_b16 v[140:141], v149 offset:5376
    ds_read_b64_tr_b16 v[142:143], v149 offset:5600
    v_mfma_f32_32x32x16_bf16 v[20:35], v[124:127], v[100:103], 0
    ds_read_b64_tr_b16 v[144:145], v149 offset:6272
    ds_read_b64_tr_b16 v[146:147], v149 offset:6496
    v_mfma_f32_32x32x16_bf16 v[20:35], v[128:131], v[104:107], v[20:35]
    s_setprio 0
    v_exp_f32 v4, v4
    v_exp_f32 v5, v5
    v_exp_f32 v6, v6
    v_exp_f32 v7, v7
    v_exp_f32 v8, v8
    v_exp_f32 v9, v9
    v_exp_f32 v10, v10
    s_setprio 1
    v_exp_f32 v11, v11
    v_exp_f32 v12, v12
    v_exp_f32 v13, v13
    v_exp_f32 v14, v14
    v_exp_f32 v15, v15
    v_exp_f32 v16, v16
    v_exp_f32 v17, v17
    v_exp_f32 v18, v18
    v_exp_f32 v19, v19
    v_exp_f32 v20, v20
    v_exp_f32 v21, v21
    v_exp_f32 v22, v22
    v_exp_f32 v23, v23
    v_exp_f32 v24, v24
    v_exp_f32 v25, v25
    v_exp_f32 v26, v26
    v_exp_f32 v27, v27
    v_exp_f32 v28, v28
    v_exp_f32 v29, v29
    v_exp_f32 v30, v30
    v_exp_f32 v31, v31
    v_exp_f32 v32, v32
    v_exp_f32 v33, v33
    v_exp_f32 v34, v34
    v_exp_f32 v35, v35
    s_setprio 3
    s_waitcnt lgkmcnt(0)
    v_smfmac_f32_32x32x32_bf16 v[68:83], v[132:135], v[4:11], v153
    v_smfmac_f32_32x32x32_bf16 v[68:83], v[136:139], v[12:19], v153
    v_smfmac_f32_32x32x32_bf16 v[68:83], v[140:143], v[20:27], v153
    v_smfmac_f32_32x32x32_bf16 v[68:83], v[144:147], v[28:35], v153
    v_mfma_f32_32x32x16_bf16 v[36:51], v[116:119], v[108:111], 0
    s_nop 7
    s_nop 1
    v_mfma_f32_32x32x16_bf16 v[36:51], v[120:123], v[112:115], v[36:51]
    ds_write_b128 v158, v[68:71] offset:0
    v_mfma_f32_32x32x16_bf16 v[52:67], v[124:127], v[108:111], 0
    ds_write_b128 v158, v[72:75] offset:1024
    ds_write_b128 v158, v[76:79] offset:2048
    v_mfma_f32_32x32x16_bf16 v[52:67], v[128:131], v[112:115], v[52:67]
    ds_write_b128 v158, v[80:83] offset:3072
    ds_add_u32 v161, v163
    s_add_u32 s88, s88, 1
    s_mov_b32 s45, 0x71800000
    s_mov_b32 s51, 0x207
    s_cmp_eq_u32 s33, 0
    s_cbranch_scc0 L_lastY
    s_setprio 0
    v_exp_f32 v36, v36
    v_exp_f32 v37, v37
    v_exp_f32 v38, v38
    v_exp_f32 v39, v39
    v_exp_f32 v40, v40
    v_exp_f32 v41, v41
    v_exp_f32 v42, v42
    s_setprio 1
    v_exp_f32 v43, v43
    v_exp_f32 v44, v44
    v_exp_f32 v45, v45
    v_exp_f32 v46, v46
    v_exp_f32 v47, v47
    v_exp_f32 v48, v48
    v_exp_f32 v49, v49
    v_exp_f32 v50, v50
    v_exp_f32 v51, v51
    v_exp_f32 v52, v52
    v_exp_f32 v53, v53
    v_exp_f32 v54, v54
    v_exp_f32 v55, v55
    v_exp_f32 v56, v56
    v_exp_f32 v57, v57
    v_exp_f32 v58, v58
    v_exp_f32 v59, v59
    v_exp_f32 v60, v60
    v_exp_f32 v61, v61
    v_exp_f32 v62, v62
    v_exp_f32 v63, v63
    v_exp_f32 v64, v64
    v_exp_f32 v65, v65
    v_exp_f32 v66, v66
    v_exp_f32 v67, v67
    s_setprio 3
    v_smfmac_f32_32x32x32_bf16 v[84:99], v[132:135], v[36:43], v153
    v_smfmac_f32_32x32x32_bf16 v[84:99], v[136:139], v[44:51], v153
    v_smfmac_f32_32x32x32_bf16 v[84:99], v[140:143], v[52:59], v153
    v_smfmac_f32_32x32x32_bf16 v[84:99], v[144:147], v[60:67], v153
    s_branch L_xch_spin
L_lastY:
    ds_read_b32 v164, v1
    ds_read_b128 v[16:19], v160 offset:3072
    ds_read_b128 v[4:7], v160 offset:0
    ds_read_b128 v[8:11], v160 offset:1024
    ds_read_b128 v[12:15], v160 offset:2048
    s_setprio 0
    v_exp_f32 v36, v36
    v_exp_f32 v37, v37
    v_exp_f32 v38, v38
    v_exp_f32 v39, v39
    v_exp_f32 v40, v40
    v_exp_f32 v41, v41
    v_exp_f32 v42, v42
    s_setprio 2
    v_exp_f32 v43, v43
    v_exp_f32 v44, v44
    v_exp_f32 v45, v45
    v_smfmac_f32_32x32x32_bf16 v[84:99], v[132:135], v[36:43], v153
    v_exp_f32 v46, v46
    v_exp_f32 v47, v47
    v_exp_f32 v48, v48
    v_exp_f32 v49, v49
    v_exp_f32 v50, v50
    v_exp_f32 v51, v51
    v_exp_f32 v52, v52
    v_exp_f32 v53, v53
    v_smfmac_f32_32x32x32_bf16 v[84:99], v[136:139], v[44:51], v153
    v_exp_f32 v54, v54
    v_exp_f32 v55, v55
    v_exp_f32 v56, v56
    v_exp_f32 v57, v57
    v_exp_f32 v58, v58
    v_exp_f32 v59, v59
    v_exp_f32 v60, v60
    v_exp_f32 v61, v61
    v_exp_f32 v62, v62
    v_smfmac_f32_32x32x32_bf16 v[84:99], v[140:143], v[52:59], v153
    v_exp_f32 v63, v63
    v_exp_f32 v64, v64
    v_exp_f32 v65, v65
    v_exp_f32 v66, v66
    v_exp_f32 v67, v67
    s_nop 0
    s_nop 0
    v_smfmac_f32_32x32x32_bf16 v[84:99], v[144:147], v[60:67], v153
    s_setprio 1
    s_waitcnt lgkmcnt(4)
    v_cmp_gt_u32 vcc, s88, v164
    s_cbranch_vccnz L_xch_spin
    s_nop 7
L_xch_ok:
    s_waitcnt lgkmcnt(3)
    v_pk_add_f32 v[96:97], v[96:97], v[16:17]
    v_pk_add_f32 v[98:99], v[98:99], v[18:19]
    v_rcp_f32 v168, v96
    s_waitcnt lgkmcnt(2)
    v_pk_add_f32 v[84:85], v[84:85], v[4:5]
    v_mov_b32 v172, v168
    v_pk_add_f32 v[86:87], v[86:87], v[6:7]
    s_waitcnt lgkmcnt(1)
    v_pk_add_f32 v[88:89], v[88:89], v[8:9]
    v_permlane32_swap_b32 v168, v172
    v_pk_add_f32 v[90:91], v[90:91], v[10:11]
    s_waitcnt lgkmcnt(0)
    v_pk_add_f32 v[92:93], v[92:93], v[12:13]
    v_pk_add_f32 v[94:95], v[94:95], v[14:15]
    v_cmp_nle_f32 vcc, 1.0, v96
    v_cmp_nge_f32 s[46:47], s45, v96
L_fin:
    v_pk_mul_f32 v[84:85], v[84:85], v[172:173] op_sel_hi:[1,0]
    v_pk_mul_f32 v[86:87], v[86:87], v[172:173] op_sel_hi:[1,0]
    v_pk_mul_f32 v[88:89], v[88:89], v[172:173] op_sel_hi:[1,0]
    v_pk_mul_f32 v[90:91], v[90:91], v[172:173] op_sel_hi:[1,0]
    v_cvt_pk_bf16_f32 v20, v84, v85
    v_cvt_pk_bf16_f32 v21, v86, v87
    v_cvt_pk_bf16_f32 v22, v88, v89
    v_cvt_pk_bf16_f32 v23, v90, v91
    ds_write_b64 v2, v[20:21]
    ds_write_b64 v2, v[22:23] offset:8
    v_pk_mul_f32 v[92:93], v[92:93], v[172:173] op_sel_hi:[1,0]
    v_pk_mul_f32 v[94:95], v[94:95], v[172:173] op_sel_hi:[1,0]
    v_pk_mul_f32 v[96:97], v[96:97], v[172:173] op_sel_hi:[1,0]
    v_pk_mul_f32 v[98:99], v[98:99], v[172:173] op_sel_hi:[1,0]
    v_cvt_pk_bf16_f32 v24, v92, v93
    v_cvt_pk_bf16_f32 v25, v94, v95
    v_cvt_pk_bf16_f32 v26, v96, v97
    v_cvt_pk_bf16_f32 v27, v98, v99
    ds_write_b64 v2, v[24:25] offset:16
    s_mov_b32 exec_hi, 0
    ds_write_b64 v2, v[26:27] offset:24
    s_mov_b32 exec_hi, -1
    ds_read_b128 v[28:31], v160
    ds_read_b128 v[32:35], v160 offset:1024
    s_setprio 0
    s_or_b64 vcc, vcc, s[46:47]
    v_pk_add_f32 v[170:171], v[84:85], v[86:87]
    v_pk_add_f32 v[174:175], v[88:89], v[90:91]
    v_pk_add_f32 v[4:5], v[92:93], v[94:95]
    v_pk_add_f32 v[6:7], v[96:97], v[98:99]
    v_pk_add_f32 v[170:171], v[170:171], v[174:175]
    v_pk_add_f32 v[4:5], v[4:5], v[6:7]
    s_mov_b32 vcc_lo, 0
    v_pk_add_f32 v[170:171], v[170:171], v[4:5]
    s_and_b64 vcc, vcc, s[90:91]
    v_add_f32 v170, v170, v171
    v_cmp_class_f32 s[48:49], v170, s51
    s_nop 0
    s_and_b64 s[48:49], s[48:49], s[90:91]
    s_or_b64 vcc, vcc, s[48:49]
    s_cbranch_vccnz L_slow
    s_waitcnt lgkmcnt(1)
    buffer_store_dwordx4 v[28:31], v3, s[20:23], s52 offen sc1
    s_mov_b32 exec_hi, 0xffff
    s_waitcnt lgkmcnt(0)
    buffer_store_dwordx4 v[32:35], v3, s[20:23], s52 offen offset:1024 sc1
L_end:
    s_endpgm
L_xch_spin:
    ds_read_b32 v164, v1
    s_waitcnt lgkmcnt(0)
    v_cmp_gt_u32 vcc, s88, v164
    s_cbranch_vccnz L_xch_spin
    ds_read_b32 v164, v1
    ds_read_b128 v[16:19], v160 offset:3072
    ds_read_b128 v[4:7], v160 offset:0
    ds_read_b128 v[8:11], v160 offset:1024
    ds_read_b128 v[12:15], v160 offset:2048
    s_setprio 3
    s_nop 0
    s_nop 0
    s_branch L_xch_ok
L_slow:
    s_waitcnt lgkmcnt(0)
    s_mov_b64 s[90:91], 0
    s_mov_b32 s26, 3670016
    s_mov_b32 s27, 0x00020000
    s_mov_b32 s30, 3670016
    s_mov_b32 s31, 0x00020000
    buffer_load_dwordx4 v[100:103], v157, s[12:15], s52 offen
    buffer_load_dwordx4 v[104:107], v157, s[12:15], s52 offen offset:16
    v_add_u32 v172, s34, v157
    v_add_u32 v173, s34, v3
    v_add_u32 v174, s50, v165
    v_cmp_eq_u32 vcc, 1, v152
    s_mov_b32 m0, s50
    v_mov_b32 v168, 0xff7fffff
    v_cndmask_b32 v174, v166, v174, vcc
    v_mov_b32 v84, 0
    v_mov_b32 v85, 0
    v_mov_b32 v86, 0
    v_mov_b32 v87, 0
    v_mov_b32 v88, 0
    v_mov_b32 v89, 0
    v_mov_b32 v90, 0
    v_mov_b32 v91, 0
    v_mov_b32 v92, 0
    v_mov_b32 v93, 0
    v_mov_b32 v94, 0
    v_mov_b32 v95, 0
    v_mov_b32 v96, 0
    v_mov_b32 v97, 0
    v_mov_b32 v98, 0
    v_mov_b32 v99, 0
    v_cmp_eq_u32 vcc, 0, v156
    s_mov_b32 s40, 0
    s_waitcnt vmcnt(0)
    v_cndmask_b32 v100, 0, v100, vcc
    v_cndmask_b32 v101, 0, v101, vcc
L_slow_loop:
    buffer_load_dwordx2 v[116:117], v172, s[24:27], s40 offen offset:0
    buffer_load_dwordx2 v[118:119], v172, s[24:27], s40 offen offset:8
    buffer_load_dwordx2 v[120:121], v172, s[24:27], s40 offen offset:16
    buffer_load_dwordx2 v[122:123], v172, s[24:27], s40 offen offset:24
    buffer_load_dwordx4 v173, s[28:31], s40 offen lds
    buffer_load_dwordx4 v173, s[28:31], s40 offen offset:1024 lds
    s_waitcnt vmcnt(0)
    ds_read_b64_tr_b16 v[132:133], v174 offset:0
    ds_read_b64_tr_b16 v[134:135], v174 offset:224
    ds_read_b64_tr_b16 v[136:137], v174 offset:896
    ds_read_b64_tr_b16 v[138:139], v174 offset:1120
    v_mfma_f32_32x32x16_bf16 v[4:19], v[116:119], v[100:103], 0
    v_mfma_f32_32x32x16_bf16 v[4:19], v[120:123], v[104:107], v[4:19]
    s_nop 15
    v_max3_f32 v169, v4, v5, v168
    v_max3_f32 v169, v6, v7, v169
    v_max3_f32 v169, v8, v9, v169
    v_max3_f32 v169, v10, v11, v169
    v_max3_f32 v169, v12, v13, v169
    v_max3_f32 v169, v14, v15, v169
    v_max3_f32 v169, v16, v17, v169
    v_max3_f32 v169, v18, v19, v169
    v_mov_b32 v170, v169
    s_nop 1
    v_permlane32_swap_b32 v169, v170
    s_nop 1
    v_max_f32 v169, v169, v170
    v_sub_f32 v170, v168, v169
    v_mul_f32 v170, s42, v170
    v_exp_f32 v170, v170
    v_mov_b32 v168, v169
    v_sub_f32 v4, v4, v168
    v_mul_f32 v4, s42, v4
    v_exp_f32 v4, v4
    v_sub_f32 v5, v5, v168
    v_mul_f32 v5, s42, v5
    v_exp_f32 v5, v5
    v_sub_f32 v6, v6, v168
    v_mul_f32 v6, s42, v6
    v_exp_f32 v6, v6
    v_sub_f32 v7, v7, v168
    v_mul_f32 v7, s42, v7
    v_exp_f32 v7, v7
    v_sub_f32 v8, v8, v168
    v_mul_f32 v8, s42, v8
    v_exp_f32 v8, v8
    v_sub_f32 v9, v9, v168
    v_mul_f32 v9, s42, v9
    v_exp_f32 v9, v9
    v_sub_f32 v10, v10, v168
    v_mul_f32 v10, s42, v10
    v_exp_f32 v10, v10
    v_sub_f32 v11, v11, v168
    v_mul_f32 v11, s42, v11
    v_exp_f32 v11, v11
    v_sub_f32 v12, v12, v168
    v_mul_f32 v12, s42, v12
    v_exp_f32 v12, v12
    v_sub_f32 v13, v13, v168
    v_mul_f32 v13, s42, v13
    v_exp_f32 v13, v13
    v_sub_f32 v14, v14, v168
    v_mul_f32 v14, s42, v14
    v_exp_f32 v14, v14
    v_sub_f32 v15, v15, v168
    v_mul_f32 v15, s42, v15
    v_exp_f32 v15, v15
    v_sub_f32 v16, v16, v168
    v_mul_f32 v16, s42, v16
    v_exp_f32 v16, v16
    v_sub_f32 v17, v17, v168
    v_mul_f32 v17, s42, v17
    v_exp_f32 v17, v17
    v_sub_f32 v18, v18, v168
    v_mul_f32 v18, s42, v18
    v_exp_f32 v18, v18
    v_sub_f32 v19, v19, v168
    v_mul_f32 v19, s42, v19
    v_exp_f32 v19, v19
    v_mul_f32 v84, v170, v84
    v_mul_f32 v85, v170, v85
    v_mul_f32 v86, v170, v86
    v_mul_f32 v87, v170, v87
    v_mul_f32 v88, v170, v88
    v_mul_f32 v89, v170, v89
    v_mul_f32 v90, v170, v90
    v_mul_f32 v91, v170, v91
    v_mul_f32 v92, v170, v92
    v_mul_f32 v93, v170, v93
    v_mul_f32 v94, v170, v94
    v_mul_f32 v95, v170, v95
    v_mul_f32 v96, v170, v96
    v_mul_f32 v97, v170, v97
    v_mul_f32 v98, v170, v98
    v_mul_f32 v99, v170, v99
    s_waitcnt lgkmcnt(0)
    s_nop 1
    v_smfmac_f32_32x32x32_bf16 v[84:99], v[132:135], v[4:11], v153
    v_smfmac_f32_32x32x32_bf16 v[84:99], v[136:139], v[12:19], v153
    s_nop 15
    s_add_u32 s40, s40, 1792
    s_cmp_lt_u32 s40, 114688
    s_cbranch_scc1 L_slow_loop
    v_rcp_f32 v168, v96
    s_nop 0
    v_mov_b32 v172, v168
    s_nop 1
    v_permlane32_swap_b32 v168, v172
    s_nop 1
    s_branch L_fin
.section .rodata,"a"
.p2align 6
.amdhsa_kernel standalone__fused_io_aware_attn__prompt_kernel
  .amdhsa_next_free_vgpr 176
  .amdhsa_next_free_sgpr 102
  .amdhsa_accum_offset 176
  .amdhsa_group_segment_fixed_size 0
  .amdhsa_kernarg_size 48
  .amdhsa_user_sgpr_count 2
  .amdhsa_user_sgpr_kernarg_segment_ptr 1
  .amdhsa_system_sgpr_workgroup_id_x 1
.end_amdhsa_kernel
```
